```python
import torch

def _softmax(x, axis=-1):
    return torch.softmax(x, dim=axis)
def _gelu(x):
    return torch.nn.functional.gelu(x, approximate="tanh")
def _silu(x):
    return torch.nn.functional.silu(x)
def _sigmoid(x):
    return torch.sigmoid(x)
def _layernorm(x, axis=-1, eps=1e-5):
    m = x.mean(dim=axis, keepdim=True)
    v = x.var(dim=axis, keepdim=True, unbiased=False)
    return (x - m) / torch.sqrt(v + eps)
def _scatter_add(tgt, idx, src, axis=0):
    return tgt.clone().index_add_(axis, idx, src)
def _segment_sum(src, seg, n):
    out = torch.zeros((n,) + src.shape[1:], dtype=src.dtype)
    return out.index_add_(0, seg, src)
def _pad(x, pw):
    flat = tuple(v for pair in reversed(pw) for v in pair)
    return torch.nn.functional.pad(x, flat)

kernel_name = 'standalone__block_sparse_attn__prompt'

def setup_inputs():

    _w = (lambda a: (lambda t: t.to(torch.bfloat16) if t.is_floating_point() else t)(torch.as_tensor(a)))
    B, H, S, D = 1, 16, 2048, 256
    bs = 64; nb = S // bs
    bm = (torch.rand(nb, nb) < 0.15).to(float)
    bm = torch.maximum(bm, torch.eye(nb, dtype=float))
    return {
        "q": _w((lambda *s: torch.randn(*s, dtype=torch.bfloat16) * 0.8)(B, H, S, D)),
        "k": _w((lambda *s: torch.randn(*s, dtype=torch.bfloat16) * 0.8)(B, H, S, D)),
        "v": _w((lambda *s: torch.randn(*s, dtype=torch.bfloat16) * 0.05)(B, H, S, D)),
        "block_mask": _w(bm),
    }

def reference(q, k, v, block_mask):
    B, H, S, D = q.shape
    bs = 64
    mask = torch.kron(block_mask, torch.ones((bs, bs), dtype=q.dtype))[:S, :S]
    scores = torch.einsum("bhqd,bhkd->bhqk", q, k) * (D ** -0.5)
    scores = torch.where(mask[None, None] > 0, scores, -1e9)
    p = _softmax(scores, axis=-1)
    return torch.einsum("bhqk,bhkd->bhqd", p, v)
```

```asm
; @launch grid=(256,1,1) block=(512,1,1) lds=163840
.amdgcn_target "amdgcn-amd-amdhsa--gfx950"
.text
.globl standalone__block_sparse_attn__prompt_kernel
.p2align 8
.type standalone__block_sparse_attn__prompt_kernel,@function
standalone__block_sparse_attn__prompt_kernel:
    s_cmp_ge_u32 s2, 256
    s_cbranch_scc1 L_end
    s_load_dwordx8 s[4:11], s[0:1], 0
    s_load_dwordx4 s[12:15], s[0:1], 32
    v_readfirstlane_b32 s24, v0
    v_and_b32 v0, 63, v0
    s_lshr_b32 s25, s2, 3
    s_and_b32 s26, s2, 7
    s_lshl_b32 s26, s26, 21
    s_add_u32 s60, s26, 0x100000
    s_lshr_b32 s24, s24, 6
    s_mov_b32 s27, 0
    s_mov_b32 s23, 0x20000
    s_cmp_lt_u32 s24, 4
    s_cbranch_scc1 L_compute
    s_sub_u32 s24, s24, 4
    v_and_b32 v1, 31, v0
    v_lshrrev_b32 v2, 5, v0
    v_lshlrev_b32 v3, 6, v1
    v_lshl_or_b32 v3, v2, 5, v3
    v_lshlrev_b32 v4, 4, v1
    v_lshl_or_b32 v4, v2, 14, v4
    s_lshr_b32 s37, s24, 1
    s_lshl_b32 s37, s37, 13
    s_and_b32 s38, s24, 1
    s_lshl_b32 s38, s38, 10
    s_add_u32 s37, s37, s38
    v_add_u32 v8, s37, v4
    v_add_u32 v9, 1008, v8
    v_add_u32 v10, 2016, v8
    v_add_u32 v11, 3024, v8
    v_add_u32 v12, 512, v8
    v_add_u32 v13, 1520, v8
    v_add_u32 v14, 2528, v8
    v_add_u32 v15, 3536, v8
    s_mul_i32 s44, s24, 8320
    s_waitcnt lgkmcnt(0)
    s_mov_b64 s[20:21], s[10:11]
    s_mov_b32 s22, 2048
    buffer_load_dwordx4 v[16:19], v3, s[20:23], 0 offen
    buffer_load_dwordx4 v[20:23], v3, s[20:23], 0 offen offset:16
L_lpass:
    s_mov_b32 s22, 0x1000000
    s_mov_b32 s34, 0
    s_mov_b32 s35, s44
    s_mov_b32 s41, 0
    s_mov_b32 s42, 0
    s_mov_b32 s29, s26
    s_mov_b32 s31, s26
    s_lshl_b32 s36, s25, 15
    s_add_u32 s36, s36, s26
    s_mov_b64 s[20:21], s[4:5]
    s_mov_b32 m0, s35
    s_add_u32 s37, s35, 4160
    buffer_load_dwordx4 v8, s[20:23], s36 offen offset:0 nt lds
    buffer_load_dwordx4 v9, s[20:23], s36 offen offset:1040 nt lds
    buffer_load_dwordx4 v10, s[20:23], s36 offen offset:2080 nt lds
    buffer_load_dwordx4 v11, s[20:23], s36 offen offset:3120 nt lds
    s_mov_b32 m0, s37
    s_add_u32 s35, s35, 33280
    buffer_load_dwordx4 v12, s[20:23], s36 offen offset:0 nt lds
    buffer_load_dwordx4 v13, s[20:23], s36 offen offset:1040 nt lds
    buffer_load_dwordx4 v14, s[20:23], s36 offen offset:2080 nt lds
    buffer_load_dwordx4 v15, s[20:23], s36 offen offset:3120 nt lds
    s_cmp_ge_u32 s35, 133120
    s_cselect_b32 s35, s44, s35
    s_cmp_lg_u32 s27, 0
    s_cbranch_scc1 L_havemask
    s_mov_b32 s37, 0x7f807f80
    s_mov_b32 s38, 0x000f000f
    s_mov_b32 s39, -1
    v_mov_b32 v5, 0
    s_waitcnt vmcnt(8)
    v_pk_add_u16 v16, v16, s39
    v_pk_add_u16 v17, v17, s39
    v_pk_add_u16 v18, v18, s39
    v_pk_add_u16 v19, v19, s39
    v_pk_add_u16 v20, v20, s39
    v_pk_add_u16 v21, v21, s39
    v_pk_add_u16 v22, v22, s39
    v_pk_add_u16 v23, v23, s39
    v_pk_min_u16 v16, v16, s37
    v_pk_min_u16 v17, v17, s37
    v_pk_min_u16 v18, v18, s37
    v_pk_min_u16 v19, v19, s37
    v_pk_min_u16 v20, v20, s37
    v_pk_min_u16 v21, v21, s37
    v_pk_min_u16 v22, v22, s37
    v_pk_min_u16 v23, v23, s37
    v_pk_sub_u16 v16, v16, s37
    v_pk_sub_u16 v17, v17, s37
    v_pk_sub_u16 v18, v18, s37
    v_pk_sub_u16 v19, v19, s37
    v_pk_sub_u16 v20, v20, s37
    v_pk_sub_u16 v21, v21, s37
    v_pk_sub_u16 v22, v22, s37
    v_pk_sub_u16 v23, v23, s37
    v_pk_lshrrev_b16 v16, s38, v16
    v_pk_lshrrev_b16 v17, s38, v17
    v_pk_lshrrev_b16 v18, s38, v18
    v_pk_lshrrev_b16 v19, s38, v19
    v_pk_lshrrev_b16 v20, s38, v20
    v_pk_lshrrev_b16 v21, s38, v21
    v_pk_lshrrev_b16 v22, s38, v22
    v_pk_lshrrev_b16 v23, s38, v23
    v_lshl_or_b32 v5, v16, 0, v5
    v_lshl_or_b32 v5, v17, 2, v5
    v_lshl_or_b32 v5, v18, 4, v5
    v_lshl_or_b32 v5, v19, 6, v5
    v_lshl_or_b32 v5, v20, 8, v5
    v_lshl_or_b32 v5, v21, 10, v5
    v_lshl_or_b32 v5, v22, 12, v5
    v_lshl_or_b32 v5, v23, 14, v5
    v_lshrrev_b32 v6, 15, v5
    v_or_b32 v5, v5, v6
    v_and_b32 v5, 0xffff, v5
    v_mov_b32 v6, v5
    s_nop 1
    v_permlane32_swap_b32 v5, v6
    s_nop 0
    v_lshl_or_b32 v5, v6, 16, v5
    v_cmp_eq_u32 vcc, 0, v5
    s_mov_b32 s43, vcc_lo
    s_nop 0
    v_cndmask_b32 v5, v5, -1, vcc
    s_nop 0
    v_readlane_b32 s32, v5, s25
L_havemask:
    s_mov_b32 s28, s32
    s_mov_b32 s30, s32
    s_ff1_i32_b32 s37, s28
    s_bitset0_b32 s28, s37
    s_lshl_b32 s37, s37, 15
    s_add_u32 s36, s37, s29
    s_mov_b64 s[20:21], s[6:7]
    s_mov_b32 m0, s35
    s_add_u32 s37, s35, 4160
    buffer_load_dwordx4 v8, s[20:23], s36 offen offset:0 lds
    buffer_load_dwordx4 v9, s[20:23], s36 offen offset:1040 lds
    buffer_load_dwordx4 v10, s[20:23], s36 offen offset:2080 lds
    buffer_load_dwordx4 v11, s[20:23], s36 offen offset:3120 lds
    s_mov_b32 m0, s37
    s_add_u32 s35, s35, 33280
    buffer_load_dwordx4 v12, s[20:23], s36 offen offset:0 lds
    buffer_load_dwordx4 v13, s[20:23], s36 offen offset:1040 lds
    buffer_load_dwordx4 v14, s[20:23], s36 offen offset:2080 lds
    buffer_load_dwordx4 v15, s[20:23], s36 offen offset:3120 lds
    s_cmp_ge_u32 s35, 133120
    s_cselect_b32 s35, s44, s35
    s_add_u32 s35, s35, 33280
    s_cmp_ge_u32 s35, 133120
    s_cselect_b32 s35, s44, s35
    s_mov_b32 s34, 2
    s_cmp_lg_u32 s27, 0
    s_cbranch_scc1 L_lloop
    v_bcnt_u32_b32 v6, v5, 0
    v_lshl_or_b32 v6, v6, 5, v1
    s_nop 0
    v_readlane_b32 s37, v6, s25
    s_nop 1
    v_cmp_ge_u32 vcc, s37, v6
    s_bcnt1_i32_b32 s38, vcc_lo
    s_mov_b32 s40, 0
    s_or_b32 s37, s40, 1024
    v_cmp_le_u32 vcc, s37, v6
    s_bcnt1_i32_b32 s39, vcc_lo
    s_cmp_ge_u32 s39, s38
    s_cselect_b32 s40, s37, s40
    s_or_b32 s37, s40, 512
    v_cmp_le_u32 vcc, s37, v6
    s_bcnt1_i32_b32 s39, vcc_lo
    s_cmp_ge_u32 s39, s38
    s_cselect_b32 s40, s37, s40
    s_or_b32 s37, s40, 256
    v_cmp_le_u32 vcc, s37, v6
    s_bcnt1_i32_b32 s39, vcc_lo
    s_cmp_ge_u32 s39, s38
    s_cselect_b32 s40, s37, s40
    s_or_b32 s37, s40, 128
    v_cmp_le_u32 vcc, s37, v6
    s_bcnt1_i32_b32 s39, vcc_lo
    s_cmp_ge_u32 s39, s38
    s_cselect_b32 s40, s37, s40
    s_or_b32 s37, s40, 64
    v_cmp_le_u32 vcc, s37, v6
    s_bcnt1_i32_b32 s39, vcc_lo
    s_cmp_ge_u32 s39, s38
    s_cselect_b32 s40, s37, s40
    s_or_b32 s37, s40, 32
    v_cmp_le_u32 vcc, s37, v6
    s_bcnt1_i32_b32 s39, vcc_lo
    s_cmp_ge_u32 s39, s38
    s_cselect_b32 s40, s37, s40
    s_or_b32 s37, s40, 16
    v_cmp_le_u32 vcc, s37, v6
    s_bcnt1_i32_b32 s39, vcc_lo
    s_cmp_ge_u32 s39, s38
    s_cselect_b32 s40, s37, s40
    s_or_b32 s37, s40, 8
    v_cmp_le_u32 vcc, s37, v6
    s_bcnt1_i32_b32 s39, vcc_lo
    s_cmp_ge_u32 s39, s38
    s_cselect_b32 s40, s37, s40
    s_or_b32 s37, s40, 4
    v_cmp_le_u32 vcc, s37, v6
    s_bcnt1_i32_b32 s39, vcc_lo
    s_cmp_ge_u32 s39, s38
    s_cselect_b32 s40, s37, s40
    s_or_b32 s37, s40, 2
    v_cmp_le_u32 vcc, s37, v6
    s_bcnt1_i32_b32 s39, vcc_lo
    s_cmp_ge_u32 s39, s38
    s_cselect_b32 s40, s37, s40
    s_or_b32 s37, s40, 1
    v_cmp_le_u32 vcc, s37, v6
    s_bcnt1_i32_b32 s39, vcc_lo
    s_cmp_ge_u32 s39, s38
    s_cselect_b32 s40, s37, s40
    s_and_b32 s40, s40, 31
    v_readlane_b32 s33, v5, s40
    s_bcnt1_i32_b32 s37, s32
    v_mov_b32 v16, s37
    s_bcnt1_i32_b32 s37, s33
    v_mov_b32 v17, s37
    v_mov_b32 v18, s40
    v_mov_b32 v19, s43
    v_mov_b32 v20, 145536
    ds_write_b128 v20, v[16:19]
    s_waitcnt lgkmcnt(0)
L_lloop:
    s_cmp_lg_u32 s28, 0
    s_cbranch_scc1 L_lK
    s_cmp_lg_u32 s41, 0
    s_cbranch_scc1 L_lNoK
    s_mov_b32 s41, 1
    s_mov_b32 s28, s33
    s_mov_b32 s29, s60
    s_lshl_b32 s36, s40, 15
    s_add_u32 s36, s36, s29
    s_mov_b64 s[20:21], s[4:5]
    s_mov_b32 m0, s35
    s_add_u32 s37, s35, 4160
    s_add_u32 s34, s34, 1
    s_cmp_gt_u32 s34, 4
    s_cbranch_scc1 L_sy0_n
    s_cmp_eq_u32 s34, 3
    s_cbranch_scc1 L_sy0_x
    s_waitcnt vmcnt(16)
    s_barrier
    s_waitcnt vmcnt(8)
L_sy0_n:
    s_waitcnt vmcnt(16)
    s_barrier
L_sy0_x:
    buffer_load_dwordx4 v8, s[20:23], s36 offen offset:0 nt lds
    buffer_load_dwordx4 v9, s[20:23], s36 offen offset:1040 nt lds
    buffer_load_dwordx4 v10, s[20:23], s36 offen offset:2080 nt lds
    buffer_load_dwordx4 v11, s[20:23], s36 offen offset:3120 nt lds
    s_mov_b32 m0, s37
    s_add_u32 s35, s35, 33280
    buffer_load_dwordx4 v12, s[20:23], s36 offen offset:0 nt lds
    buffer_load_dwordx4 v13, s[20:23], s36 offen offset:1040 nt lds
    buffer_load_dwordx4 v14, s[20:23], s36 offen offset:2080 nt lds
    buffer_load_dwordx4 v15, s[20:23], s36 offen offset:3120 nt lds
    s_cmp_ge_u32 s35, 133120
    s_cselect_b32 s35, s44, s35
L_lK:
    s_ff1_i32_b32 s37, s28
    s_bitset0_b32 s28, s37
    s_lshl_b32 s37, s37, 15
    s_add_u32 s36, s37, s29
    s_mov_b64 s[20:21], s[6:7]
    s_mov_b32 m0, s35
    s_add_u32 s37, s35, 4160
    s_add_u32 s34, s34, 1
    s_cmp_gt_u32 s34, 4
    s_cbranch_scc1 L_sy1_n
    s_cmp_eq_u32 s34, 3
    s_cbranch_scc1 L_sy1_x
    s_waitcnt vmcnt(16)
    s_barrier
    s_waitcnt vmcnt(8)
L_sy1_n:
    s_waitcnt vmcnt(16)
    s_barrier
L_sy1_x:
    buffer_load_dwordx4 v8, s[20:23], s36 offen offset:0 lds
    buffer_load_dwordx4 v9, s[20:23], s36 offen offset:1040 lds
    buffer_load_dwordx4 v10, s[20:23], s36 offen offset:2080 lds
    buffer_load_dwordx4 v11, s[20:23], s36 offen offset:3120 lds
    s_mov_b32 m0, s37
    s_add_u32 s35, s35, 33280
    buffer_load_dwordx4 v12, s[20:23], s36 offen offset:0 lds
    buffer_load_dwordx4 v13, s[20:23], s36 offen offset:1040 lds
    buffer_load_dwordx4 v14, s[20:23], s36 offen offset:2080 lds
    buffer_load_dwordx4 v15, s[20:23], s36 offen offset:3120 lds
    s_cmp_ge_u32 s35, 133120
    s_cselect_b32 s35, s44, s35
L_lV:
    s_cmp_lg_u32 s30, 0
    s_cbranch_scc1 L_lV2
    s_mov_b32 s42, 1
    s_mov_b32 s30, s33
    s_mov_b32 s31, s60
L_lV2:
    s_ff1_i32_b32 s37, s30
    s_bitset0_b32 s30, s37
    s_lshl_b32 s37, s37, 15
    s_add_u32 s36, s37, s31
    s_mov_b64 s[20:21], s[8:9]
    s_mov_b32 m0, s35
    s_add_u32 s37, s35, 4160
    s_add_u32 s34, s34, 1
    s_cmp_gt_u32 s34, 4
    s_cbranch_scc1 L_sy2_n
    s_cmp_eq_u32 s34, 3
    s_cbranch_scc1 L_sy2_x
    s_waitcnt vmcnt(16)
    s_barrier
    s_waitcnt vmcnt(8)
L_sy2_n:
    s_waitcnt vmcnt(16)
    s_barrier
L_sy2_x:
    buffer_load_dwordx4 v8, s[20:23], s36 offen offset:0 lds
    buffer_load_dwordx4 v9, s[20:23], s36 offen offset:1040 lds
    buffer_load_dwordx4 v10, s[20:23], s36 offen offset:2080 lds
    buffer_load_dwordx4 v11, s[20:23], s36 offen offset:3120 lds
    s_mov_b32 m0, s37
    s_add_u32 s35, s35, 33280
    buffer_load_dwordx4 v12, s[20:23], s36 offen offset:0 lds
    buffer_load_dwordx4 v13, s[20:23], s36 offen offset:1040 lds
    buffer_load_dwordx4 v14, s[20:23], s36 offen offset:2080 lds
    buffer_load_dwordx4 v15, s[20:23], s36 offen offset:3120 lds
    s_cmp_ge_u32 s35, 133120
    s_cselect_b32 s35, s44, s35
    s_branch L_lloop
L_lNoK:
    s_add_u32 s35, s35, 33280
    s_cmp_ge_u32 s35, 133120
    s_cselect_b32 s35, s44, s35
    s_waitcnt vmcnt(16)
    s_barrier
    s_cmp_lg_u32 s30, 0
    s_cbranch_scc1 L_lV3
    s_mov_b32 s30, s33
    s_mov_b32 s31, s60
L_lV3:
    s_ff1_i32_b32 s37, s30
    s_bitset0_b32 s30, s37
    s_lshl_b32 s37, s37, 15
    s_add_u32 s36, s37, s31
    s_mov_b64 s[20:21], s[8:9]
    s_mov_b32 m0, s35
    s_add_u32 s37, s35, 4160
    s_waitcnt vmcnt(8)
    s_barrier
    buffer_load_dwordx4 v8, s[20:23], s36 offen offset:0 lds
    buffer_load_dwordx4 v9, s[20:23], s36 offen offset:1040 lds
    buffer_load_dwordx4 v10, s[20:23], s36 offen offset:2080 lds
    buffer_load_dwordx4 v11, s[20:23], s36 offen offset:3120 lds
    s_mov_b32 m0, s37
    s_add_u32 s35, s35, 33280
    buffer_load_dwordx4 v12, s[20:23], s36 offen offset:0 lds
    buffer_load_dwordx4 v13, s[20:23], s36 offen offset:1040 lds
    buffer_load_dwordx4 v14, s[20:23], s36 offen offset:2080 lds
    buffer_load_dwordx4 v15, s[20:23], s36 offen offset:3120 lds
    s_cmp_ge_u32 s35, 133120
    s_cselect_b32 s35, s44, s35
    s_waitcnt vmcnt(8)
    s_barrier
    s_barrier
    s_waitcnt vmcnt(0)
    s_barrier
    s_barrier
    s_barrier
    v_mov_b32 v20, 145536
    ds_read_b32 v16, v20 offset:144
    s_waitcnt lgkmcnt(0)
    v_readfirstlane_b32 s27, v16
    s_nop 3
    s_cmp_lg_u32 s27, 0
    s_cbranch_scc1 L_lpass
    s_endpgm
L_compute:
    s_and_b32 s36, s24, 1
    s_lshr_b32 s37, s24, 1
    v_and_b32 v1, 31, v0
    v_lshrrev_b32 v2, 5, v0
    v_and_b32 v3, 3, v0
    v_bfe_u32 v4, v0, 2, 2
    v_and_b32 v5, 16, v0
    v_lshl_or_b32 v6, v3, 2, v4
    v_or_b32 v6, v6, v5
    v_mul_u32_u24 v6, 1040, v6
    v_lshl_add_u32 v6, v2, 4, v6
    s_lshl_b32 s45, s36, 9
    s_lshl_b32 s46, s37, 9
    v_add_u32 v227, s45, v6
    v_add_u32 v226, s46, v6
    v_lshl_add_u32 v6, v4, 2, v2
    v_mul_u32_u24 v6, 1040, v6
    v_lshl_add_u32 v6, v5, 1, v6
    v_lshl_add_u32 v6, v3, 3, v6
    s_lshl_b32 s45, s24, 7
    v_add_u32 v6, s45, v6
    v_add_u32 v232, s46, v6
    s_xor_b32 s46, s46, 512
    v_add_u32 v233, s46, v6
    v_lshlrev_b32 v6, 4, v0
    s_lshl_b32 s45, s36, 12
    s_lshl_b32 s46, s37, 11
    s_or_b32 s45, s45, s46
    s_xor_b32 s46, s45, 0
    s_add_u32 s46, s46, 133120
    v_add_u32 v234, s46, v6
    s_xor_b32 s46, s45, 2048
    s_add_u32 s46, s46, 133120
    v_add_u32 v235, s46, v6
    s_xor_b32 s46, s45, 4096
    s_add_u32 s46, s46, 133120
    v_add_u32 v236, s46, v6
    s_xor_b32 s46, s45, 6144
    s_add_u32 s46, s46, 133120
    v_add_u32 v237, s46, v6
    v_lshlrev_b32 v6, 4, v1
    s_lshl_b32 s45, s36, 9
    s_add_u32 s46, s45, 141312
    v_add_u32 v239, s46, v6
    v_xor_b32 v240, 0x200, v239
    v_lshl_add_u32 v238, v2, 2, v239
    s_lshl_b32 s46, s37, 3
    v_add_u32 v238, s46, v238
    v_add_u32 v247, 3072, v238
    s_mul_i32 s45, s24, 4608
    s_add_u32 s45, s45, 145408
    v_mul_u32_u24 v6, 144, v1
    v_lshl_add_u32 v6, v2, 3, v6
    v_add_u32 v248, s45, v6
    v_lshrrev_b32 v7, 3, v0
    v_and_b32 v8, 7, v0
    v_mul_u32_u24 v6, 144, v7
    v_lshl_add_u32 v6, v8, 4, v6
    v_add_u32 v249, s45, v6
    v_lshlrev_b32 v6, 9, v7
    v_lshl_add_u32 v6, v8, 4, v6
    s_lshl_b32 s45, s36, 14
    s_lshl_b32 s46, s24, 7
    s_add_u32 s45, s45, s46
    v_add_u32 v246, s45, v6
    v_mov_b32 v244, 0
    v_mov_b32 v243, 0
    v_mov_b32 v251, 145536
    s_mov_b32 s35, 0
    s_mov_b32 s44, 66560
    s_waitcnt lgkmcnt(0)
    s_mov_b64 s[20:21], s[12:13]
    s_mov_b32 s22, 0x1000000
    v_mov_b32 v224, v226
    v_mov_b32 v228, v232
    v_mov_b32 v229, v233
    v_lshlrev_b32 v225, 1, v226
    v_lshlrev_b32 v230, 1, v232
    v_lshlrev_b32 v231, 1, v233
    s_mov_b32 s42, 0
    s_mov_b32 s43, 0
    s_mov_b32 s28, 0
    s_mov_b32 s41, 1
    s_mov_b32 s40, -1
    s_mov_b32 s38, 1
    s_mov_b32 s30, 1
    s_mov_b64 vcc, -1
    s_mov_b32 s22, 0
    s_mov_b32 s33, 0
    s_cmp_eq_u32 s24, 1
    s_cbranch_scc1 L_q
    s_cmp_eq_u32 s24, 0
    s_cbranch_scc1 L_w0
    v_xor_b32 v239, 0x400, v239
    v_xor_b32 v240, 0x400, v240
    s_cmp_eq_u32 s24, 2
    s_cbranch_scc1 L_qe
    s_mov_b32 s38, 0
    s_branch L_epi
L_w0:
    v_xor_b32 v247, 0x400, v247
    s_branch L_vtailQ
L_cpass:
    s_mov_b64 vcc, 0
    s_mov_b32 s35, 0
    s_mov_b32 s22, 0x1000000
    s_barrier
    ds_read_b128 v[152:155], v251
    s_mov_b32 s42, 0
    s_mov_b32 s28, -1
    s_lshl_b32 s33, s25, 15
    s_add_u32 s33, s33, s26
    s_waitcnt lgkmcnt(0)
    v_readfirstlane_b32 s29, v152
    v_readfirstlane_b32 s30, v153
    v_readfirstlane_b32 s34, v154
    v_readfirstlane_b32 s36, v155
    s_nop 3
    s_add_u32 s30, s30, s29
    s_bitcmp1_b32 s36, s25
    s_cselect_b32 s31, 0, 1035512379
    s_bitcmp1_b32 s36, s34
    s_cselect_b32 s32, 0, 1035512379
    s_lshl_b32 s34, s34, 15
    s_add_u32 s34, s34, s60
    s_sub_u32 s40, s29, 1
    s_bitcmp1_b32 s29, 0
    s_mov_b32 s43, 33280
    s_cselect_b32 s43, 99840, s43
    s_cmp_eq_u32 s27, 1
    s_cselect_b32 s39, 4, 0
    s_branch L_vtailQ
L_qskip:
    v_add_f32 v250, v241, v242
    s_andn2_b32 s38, s38, 4
    s_mov_b32 s41, s30
    ds_write_b32 v238, v250 offset:1024
    v_sub_u32 v228, v230, v228
    v_sub_u32 v229, v231, v229
    v_sub_u32 v224, v225, v224
    s_waitcnt lgkmcnt(0)
    s_cbranch_vccnz L_nb1
    s_barrier
L_nb1:
    ds_read_b64_tr_b16 v[176:177], v228 offset:0
    ds_read_b64_tr_b16 v[178:179], v228 offset:2080
    ds_read_b64_tr_b16 v[180:181], v228 offset:64
    ds_read_b64_tr_b16 v[182:183], v228 offset:2144
    ds_read_b128 v[152:155], v236 offset:0
    ds_read_b64_tr_b16 v[184:185], v228 offset:16640
    ds_read_b64_tr_b16 v[186:187], v228 offset:18720
    ds_read_b64_tr_b16 v[188:189], v228 offset:16704
    ds_read_b64_tr_b16 v[190:191], v228 offset:18784
    ds_read_b128 v[156:159], v236 offset:1024
    ds_read_b64_tr_b16 v[192:193], v229 offset:0
    ds_read_b64_tr_b16 v[194:195], v229 offset:2080
    ds_read_b64_tr_b16 v[196:197], v229 offset:64
    ds_read_b64_tr_b16 v[198:199], v229 offset:2144
    ds_read_b128 v[160:163], v235 offset:0
    s_cmp_lg_u32 s38, 0
    ds_read_b128 v[164:167], v237 offset:0
    ds_read_b64_tr_b16 v[200:201], v229 offset:16640
    s_cbranch_scc0 L_vnorm
L_vspec:
    s_bitcmp1_b32 s38, 2
    s_cbranch_scc0 L_vs2
    s_nop 7
    v_max3_f32 v245, v128, v129, v245
    v_max3_f32 v245, v130, v131, v245
    v_max3_f32 v245, v132, v133, v245
    v_max3_f32 v245, v134, v135, v245
    v_max3_f32 v245, v136, v137, v245
    v_max3_f32 v245, v138, v139, v245
    v_max3_f32 v245, v140, v141, v245
    v_max3_f32 v245, v142, v143, v245
L_vs2:
    s_bitcmp1_b32 s38, 0
    s_cbranch_scc0 L_vnorm
L_vfirst:
    s_and_b32 s38, s38, 4
    s_waitcnt lgkmcnt(13)
    v_mfma_f32_32x32x16_bf16 v[0:15], v[176:179], v[144:147], 0
    ds_read_b64_tr_b16 v[202:203], v229 offset:18720
    ds_read_b64_tr_b16 v[204:205], v229 offset:16704
    ds_read_b64_tr_b16 v[206:207], v229 offset:18784
    s_add_u32 s28, s28, 1
    v_mfma_f32_32x32x16_bf16 v[16:31], v[180:183], v[144:147], 0
    ds_read_b128 v[168:171], v235 offset:1024
    ds_read_b128 v[172:175], v237 offset:1024
    v_fma_f32 v128, v128, s32, v244
    v_fma_f32 v129, v129, s32, v244
    v_fma_f32 v130, v130, s32, v244
    v_exp_f32 v128, v128
    v_fma_f32 v131, v131, s32, v244
    s_waitcnt lgkmcnt(15)
    v_mfma_f32_32x32x16_bf16 v[32:47], v[176:179], v[152:155], 0
    v_exp_f32 v129, v129
    v_fma_f32 v132, v132, s32, v244
    v_exp_f32 v130, v130
    v_fma_f32 v133, v133, s32, v244
    v_mfma_f32_32x32x16_bf16 v[48:63], v[180:183], v[152:155], 0
    v_exp_f32 v131, v131
    v_fma_f32 v134, v134, s32, v244
    v_exp_f32 v132, v132
    v_fma_f32 v135, v135, s32, v244
    s_branch L_vmid
L_vtailQ:
    v_add_u32 v224, s42, v227
    ds_write_b128 v234, v[144:147]
    ds_write_b128 v234, v[148:151] offset:1024
    ds_read_b128 v[64:67], v224 offset:0
    ds_read_b128 v[68:71], v224 offset:32
    ds_read_b128 v[72:75], v224 offset:64
    ds_read_b128 v[76:79], v224 offset:96
    v_mfma_f32_32x32x16_bf16 v[0:15], v[200:203], v[168:171], v[0:15]
    ds_read_b128 v[80:83], v224 offset:128
    ds_read_b128 v[84:87], v224 offset:160
    ds_read_b128 v[88:91], v224 offset:192
    ds_read_b128 v[92:95], v224 offset:224
    v_mfma_f32_32x32x16_bf16 v[16:31], v[204:207], v[168:171], v[16:31]
    ds_read_b128 v[96:99], v224 offset:256
    ds_read_b128 v[100:103], v224 offset:288
    ds_read_b128 v[104:107], v224 offset:320
    ds_read_b128 v[108:111], v224 offset:352
    v_add_f32 v241, v130, v241
    v_add_f32 v242, v131, v242
    v_mfma_f32_32x32x16_bf16 v[32:47], v[200:203], v[172:175], v[32:47]
    ds_read_b128 v[112:115], v224 offset:384
    ds_read_b128 v[116:119], v224 offset:416
    ds_read_b128 v[120:123], v224 offset:448
    ds_read_b128 v[124:127], v224 offset:480
    v_add_f32 v241, v132, v241
    v_add_f32 v242, v133, v242
    v_add_f32 v241, v134, v241
    v_add_f32 v242, v135, v242
    v_add_f32 v241, v136, v241
    v_add_f32 v242, v137, v242
    v_mfma_f32_32x32x16_bf16 v[48:63], v[204:207], v[172:175], v[48:63]
    v_add_f32 v241, v138, v241
    v_add_f32 v242, v139, v242
    v_add_f32 v241, v140, v241
    v_add_f32 v242, v141, v242
    v_add_f32 v241, v142, v241
    v_add_f32 v242, v143, v242
    v_add_f32 v250, v241, v242
    ds_write_b32 v247, v245
    ds_write_b32 v238, v250
    v_mov_b32 v241, 0
    v_mov_b32 v242, 0
    s_add_u32 s41, s28, 1
    s_cmp_eq_u32 s28, 0
    s_addc_u32 s38, s39, 0
    v_add_u32 v228, s42, v232
    v_add_u32 v229, s42, v233
    s_add_u32 s36, s42, 33280
    s_cmp_eq_u32 s36, 133120
    s_cselect_b32 s36, 0, s36
    v_add_u32 v224, s36, v226
    s_cmp_eq_u32 s42, 0
    s_cselect_b32 s36, 133120, s44
    s_cselect_b32 s37, s44, 133120
    v_lshl_add_u32 v225, v226, 1, s36
    v_lshl_add_u32 v230, v232, 1, s37
    v_lshl_add_u32 v231, v233, 1, s37
    s_mov_b32 s42, s43
    v_xor_b32 v247, 0x400, v247
    v_mov_b32 v245, 0xff800000
    s_mov_b32 s36, s32
    s_mov_b32 s32, s31
    s_mov_b32 s31, s36
    v_swap_b32 v244, v243
    s_waitcnt lgkmcnt(0)
    s_cbranch_vccnz L_nb2
    s_barrier
L_nb2:
    ds_read_b128 v[208:211], v224 offset:0
    ds_read_b128 v[212:215], v224 offset:32
    ds_read_b128 v[216:219], v224 offset:64
    ds_read_b128 v[220:223], v224 offset:96
    ds_read_b128 v[176:179], v224 offset:128
    ds_read_b128 v[180:183], v224 offset:160
    ds_read_b128 v[184:187], v224 offset:192
    s_cbranch_vccnz L_cpass
L_q:
    s_waitcnt lgkmcnt(5)
    v_mfma_f32_32x32x16_bf16 v[128:143], v[208:211], v[64:67], 0
    ds_read_b128 v[188:191], v224 offset:224
    ds_read_b128 v[192:195], v224 offset:256
    v_mfma_f32_32x32x16_bf16 v[128:143], v[212:215], v[68:71], v[128:143]
    ds_read_b128 v[196:199], v224 offset:288
    s_waitcnt lgkmcnt(6)
    v_mfma_f32_32x32x16_bf16 v[128:143], v[216:219], v[72:75], v[128:143]
    ds_read_b128 v[200:203], v224 offset:320
    ds_read_b128 v[204:207], v224 offset:352
    v_mfma_f32_32x32x16_bf16 v[128:143], v[220:223], v[76:79], v[128:143]
    ds_read_b128 v[208:211], v224 offset:384
    ds_read_b128 v[212:215], v224 offset:416
    s_waitcnt lgkmcnt(8)
    v_mfma_f32_32x32x16_bf16 v[128:143], v[176:179], v[80:83], v[128:143]
    ds_read_b128 v[216:219], v224 offset:448
    v_mfma_f32_32x32x16_bf16 v[128:143], v[180:183], v[84:87], v[128:143]
    ds_read_b128 v[220:223], v224 offset:480
    s_waitcnt lgkmcnt(8)
    v_mfma_f32_32x32x16_bf16 v[128:143], v[184:187], v[88:91], v[128:143]
    v_mfma_f32_32x32x16_bf16 v[128:143], v[188:191], v[92:95], v[128:143]
    s_waitcnt lgkmcnt(6)
    v_mfma_f32_32x32x16_bf16 v[128:143], v[192:195], v[96:99], v[128:143]
    v_sub_u32 v228, v230, v228
    v_sub_u32 v229, v231, v229
    v_mfma_f32_32x32x16_bf16 v[128:143], v[196:199], v[100:103], v[128:143]
    v_sub_u32 v224, v225, v224
    s_waitcnt lgkmcnt(4)
    v_mfma_f32_32x32x16_bf16 v[128:143], v[200:203], v[104:107], v[128:143]
    s_waitcnt lgkmcnt(0)
    s_cbranch_vccnz L_nb3
    s_barrier
L_nb3:
    ds_read_b64_tr_b16 v[176:177], v228 offset:0
    ds_read_b64_tr_b16 v[178:179], v228 offset:2080
    ds_read_b64_tr_b16 v[180:181], v228 offset:64
    v_mfma_f32_32x32x16_bf16 v[128:143], v[204:207], v[108:111], v[128:143]
    ds_read_b64_tr_b16 v[182:183], v228 offset:2144
    ds_read_b128 v[152:155], v236 offset:0
    ds_read_b64_tr_b16 v[184:185], v228 offset:16640
    v_mfma_f32_32x32x16_bf16 v[128:143], v[208:211], v[112:115], v[128:143]
    ds_read_b64_tr_b16 v[186:187], v228 offset:18720
    ds_read_b64_tr_b16 v[188:189], v228 offset:16704
    ds_read_b64_tr_b16 v[190:191], v228 offset:18784
    v_mfma_f32_32x32x16_bf16 v[128:143], v[212:215], v[116:119], v[128:143]
    ds_read_b128 v[156:159], v236 offset:1024
    ds_read_b64_tr_b16 v[192:193], v229 offset:0
    ds_read_b64_tr_b16 v[194:195], v229 offset:2080
    v_mfma_f32_32x32x16_bf16 v[128:143], v[216:219], v[120:123], v[128:143]
    ds_read_b64_tr_b16 v[196:197], v229 offset:64
    ds_read_b64_tr_b16 v[198:199], v229 offset:2144
    ds_read_b128 v[160:163], v235 offset:0
    s_cmp_lg_u32 s38, 0
    v_mfma_f32_32x32x16_bf16 v[128:143], v[220:223], v[124:127], v[128:143]
    ds_read_b128 v[164:167], v237 offset:0
    ds_read_b64_tr_b16 v[200:201], v229 offset:16640
    s_cbranch_scc1 L_vspec
L_vnorm:
    s_waitcnt lgkmcnt(13)
    v_mfma_f32_32x32x16_bf16 v[0:15], v[176:179], v[144:147], v[0:15]
    ds_read_b64_tr_b16 v[202:203], v229 offset:18720
    ds_read_b64_tr_b16 v[204:205], v229 offset:16704
    ds_read_b64_tr_b16 v[206:207], v229 offset:18784
    s_add_u32 s28, s28, 1
    s_nop 1
    v_mfma_f32_32x32x16_bf16 v[16:31], v[180:183], v[144:147], v[16:31]
    ds_read_b128 v[168:171], v235 offset:1024
    ds_read_b128 v[172:175], v237 offset:1024
    v_fma_f32 v128, v128, s32, v244
    v_fma_f32 v129, v129, s32, v244
    v_fma_f32 v130, v130, s32, v244
    v_exp_f32 v128, v128
    v_fma_f32 v131, v131, s32, v244
    s_waitcnt lgkmcnt(15)
    v_mfma_f32_32x32x16_bf16 v[32:47], v[176:179], v[152:155], v[32:47]
    v_exp_f32 v129, v129
    v_fma_f32 v132, v132, s32, v244
    v_exp_f32 v130, v130
    v_fma_f32 v133, v133, s32, v244
    v_mfma_f32_32x32x16_bf16 v[48:63], v[180:183], v[152:155], v[48:63]
    v_exp_f32 v131, v131
    v_fma_f32 v134, v134, s32, v244
    v_exp_f32 v132, v132
    v_fma_f32 v135, v135, s32, v244
L_vmid:
    s_waitcnt lgkmcnt(13)
    v_mfma_f32_32x32x16_bf16 v[0:15], v[184:187], v[148:151], v[0:15]
    v_exp_f32 v133, v133
    v_fma_f32 v136, v136, s32, v244
    v_exp_f32 v134, v134
    v_fma_f32 v137, v137, s32, v244
    v_mfma_f32_32x32x16_bf16 v[16:31], v[188:191], v[148:151], v[16:31]
    v_exp_f32 v135, v135
    v_fma_f32 v138, v138, s32, v244
    v_exp_f32 v136, v136
    v_fma_f32 v139, v139, s32, v244
    s_waitcnt lgkmcnt(12)
    v_mfma_f32_32x32x16_bf16 v[32:47], v[184:187], v[156:159], v[32:47]
    v_exp_f32 v137, v137
    v_fma_f32 v140, v140, s32, v244
    v_exp_f32 v138, v138
    v_fma_f32 v141, v141, s32, v244
    v_mfma_f32_32x32x16_bf16 v[48:63], v[188:191], v[156:159], v[48:63]
    v_exp_f32 v139, v139
    v_fma_f32 v142, v142, s32, v244
    v_exp_f32 v140, v140
    v_fma_f32 v143, v143, s32, v244
    s_waitcnt lgkmcnt(7)
    v_mfma_f32_32x32x16_bf16 v[0:15], v[192:195], v[160:163], v[0:15]
    v_exp_f32 v141, v141
    v_cvt_pk_bf16_f32 v144, v128, v129
    v_exp_f32 v142, v142
    v_cvt_pk_bf16_f32 v145, v130, v131
    v_mfma_f32_32x32x16_bf16 v[16:31], v[196:199], v[160:163], v[16:31]
    v_exp_f32 v143, v143
    v_cvt_pk_bf16_f32 v146, v132, v133
    v_cvt_pk_bf16_f32 v147, v134, v135
    v_cvt_pk_bf16_f32 v148, v136, v137
    s_waitcnt lgkmcnt(6)
    v_mfma_f32_32x32x16_bf16 v[32:47], v[192:195], v[164:167], v[32:47]
    v_cvt_pk_bf16_f32 v149, v138, v139
    v_cvt_pk_bf16_f32 v150, v140, v141
    v_cvt_pk_bf16_f32 v151, v142, v143
    v_add_f32 v241, v128, v241
    v_add_f32 v242, v129, v242
    s_cmp_eq_u32 s28, s40
    v_mfma_f32_32x32x16_bf16 v[48:63], v[196:199], v[164:167], v[48:63]
    s_waitcnt lgkmcnt(0)
    s_cbranch_vccnz L_nb4
    s_barrier
L_nb4:
    s_cbranch_scc1 L_vtailQ
    ds_write_b128 v234, v[144:147]
    ds_write_b128 v234, v[148:151] offset:1024
    v_mfma_f32_32x32x16_bf16 v[0:15], v[200:203], v[168:171], v[0:15]
    v_mfma_f32_32x32x16_bf16 v[16:31], v[204:207], v[168:171], v[16:31]
    ds_read_b128 v[208:211], v224 offset:0
    ds_read_b128 v[212:215], v224 offset:32
    ds_read_b128 v[216:219], v224 offset:64
    v_add_f32 v241, v130, v241
    v_add_f32 v242, v131, v242
    v_mfma_f32_32x32x16_bf16 v[32:47], v[200:203], v[172:175], v[32:47]
    ds_read_b128 v[220:223], v224 offset:96
    ds_read_b128 v[176:179], v224 offset:128
    v_add_f32 v241, v132, v241
    v_add_f32 v242, v133, v242
    v_add_f32 v241, v134, v241
    v_add_f32 v242, v135, v242
    v_add_f32 v241, v136, v241
    v_add_f32 v242, v137, v242
    s_cmp_lg_u32 s28, s41
    v_mfma_f32_32x32x16_bf16 v[48:63], v[204:207], v[172:175], v[48:63]
    ds_read_b128 v[180:183], v224 offset:160
    ds_read_b128 v[184:187], v224 offset:192
    v_add_f32 v241, v138, v241
    v_add_f32 v242, v139, v242
    v_add_f32 v241, v140, v241
    v_add_f32 v242, v141, v242
    v_add_f32 v241, v142, v241
    v_add_f32 v242, v143, v242
    s_cbranch_scc1 L_q
L_event:
    s_cbranch_vccnz L_cpass
    s_sub_u32 s41, s30, 1
    s_cmp_eq_u32 s28, s29
    s_cbranch_scc0 L_ev2
    s_or_b32 s38, s39, 1
    s_cmp_eq_u32 s28, s41
    s_cbranch_scc1 L_epi
L_qe:
    ds_read_b128 v[152:155], v239
    ds_read_b128 v[156:159], v240
    s_waitcnt lgkmcnt(7)
    v_mfma_f32_32x32x16_bf16 v[128:143], v[208:211], v[64:67], 0
    ds_read_b128 v[188:191], v224 offset:224
    ds_read_b128 v[192:195], v224 offset:256
    v_mfma_f32_32x32x16_bf16 v[128:143], v[212:215], v[68:71], v[128:143]
    ds_read_b128 v[196:199], v224 offset:288
    s_waitcnt lgkmcnt(3)
    s_mov_b32 s36, 0x30800000
    s_mov_b32 s37, 0x1e000000
    v_add_f32 v152, v152, v153
    v_add_f32 v154, v154, v155
    v_add_f32 v156, v156, v157
    v_add_f32 v158, v158, v159
    v_add_f32 v152, v152, v154
    v_mfma_f32_32x32x16_bf16 v[128:143], v[216:219], v[72:75], v[128:143]
    ds_read_b128 v[200:203], v224 offset:320
    ds_read_b128 v[204:207], v224 offset:352
    v_add_f32 v156, v156, v158
    v_subrev_u32 v153, s36, v152
    v_rcp_f32 v152, v152
    v_subrev_u32 v157, s36, v156
    v_rcp_f32 v156, v156
    v_max_u32 v153, v153, v157
    v_cmp_lt_u32 s[58:59], s37, v153
    v_mfma_f32_32x32x16_bf16 v[128:143], v[220:223], v[76:79], v[128:143]
    ds_read_b128 v[208:211], v224 offset:384
    ds_read_b128 v[212:215], v224 offset:416
    v_xor_b32 v239, 0x400, v239
    v_xor_b32 v240, 0x400, v240
    v_mul_f32 v0, v152, v0
    v_mul_f32 v1, v152, v1
    v_mul_f32 v2, v152, v2
    v_mul_f32 v3, v152, v3
    v_cvt_pk_bf16_f32 v0, v0, v1
    v_mfma_f32_32x32x16_bf16 v[128:143], v[176:179], v[80:83], v[128:143]
    ds_read_b128 v[216:219], v224 offset:448
    v_cvt_pk_bf16_f32 v1, v2, v3
    v_mul_f32 v4, v152, v4
    v_mul_f32 v5, v152, v5
    v_mul_f32 v6, v152, v6
    v_mul_f32 v7, v152, v7
    v_cvt_pk_bf16_f32 v2, v4, v5
    v_cvt_pk_bf16_f32 v3, v6, v7
    v_mfma_f32_32x32x16_bf16 v[128:143], v[180:183], v[84:87], v[128:143]
    ds_read_b128 v[220:223], v224 offset:480
    v_mul_f32 v8, v152, v8
    v_mul_f32 v9, v152, v9
    v_mul_f32 v10, v152, v10
    v_mul_f32 v11, v152, v11
    v_cvt_pk_bf16_f32 v4, v8, v9
    v_cvt_pk_bf16_f32 v5, v10, v11
    v_mul_f32 v12, v152, v12
    s_waitcnt lgkmcnt(8)
    v_mfma_f32_32x32x16_bf16 v[128:143], v[184:187], v[88:91], v[128:143]
    v_mul_f32 v13, v152, v13
    v_mul_f32 v14, v152, v14
    v_mul_f32 v15, v152, v15
    v_cvt_pk_bf16_f32 v6, v12, v13
    v_cvt_pk_bf16_f32 v7, v14, v15
    v_mul_f32 v16, v152, v16
    v_mul_f32 v17, v152, v17
    v_mfma_f32_32x32x16_bf16 v[128:143], v[188:191], v[92:95], v[128:143]
    v_mul_f32 v18, v152, v18
    v_mul_f32 v19, v152, v19
    v_cvt_pk_bf16_f32 v8, v16, v17
    v_cvt_pk_bf16_f32 v9, v18, v19
    v_mul_f32 v20, v152, v20
    v_mul_f32 v21, v152, v21
    v_mul_f32 v22, v152, v22
    s_waitcnt lgkmcnt(6)
    v_mfma_f32_32x32x16_bf16 v[128:143], v[192:195], v[96:99], v[128:143]
    v_mul_f32 v23, v152, v23
    v_cvt_pk_bf16_f32 v10, v20, v21
    v_cvt_pk_bf16_f32 v11, v22, v23
    v_mul_f32 v24, v152, v24
    v_mul_f32 v25, v152, v25
    v_mul_f32 v26, v152, v26
    v_mul_f32 v27, v152, v27
    v_mfma_f32_32x32x16_bf16 v[128:143], v[196:199], v[100:103], v[128:143]
    v_cvt_pk_bf16_f32 v12, v24, v25
    v_cvt_pk_bf16_f32 v13, v26, v27
    v_mul_f32 v28, v152, v28
    v_mul_f32 v29, v152, v29
    v_mul_f32 v30, v152, v30
    v_mul_f32 v31, v152, v31
    v_cvt_pk_bf16_f32 v14, v28, v29
    s_waitcnt lgkmcnt(4)
    v_mfma_f32_32x32x16_bf16 v[128:143], v[200:203], v[104:107], v[128:143]
    v_cvt_pk_bf16_f32 v15, v30, v31
    v_mul_f32 v32, v156, v32
    v_mul_f32 v33, v156, v33
    v_mul_f32 v34, v156, v34
    v_mul_f32 v35, v156, v35
    v_cvt_pk_bf16_f32 v32, v32, v33
    v_cvt_pk_bf16_f32 v33, v34, v35
    v_mfma_f32_32x32x16_bf16 v[128:143], v[204:207], v[108:111], v[128:143]
    v_mul_f32 v36, v156, v36
    v_mul_f32 v37, v156, v37
    v_mul_f32 v38, v156, v38
    v_mul_f32 v39, v156, v39
    v_cvt_pk_bf16_f32 v34, v36, v37
    v_cvt_pk_bf16_f32 v35, v38, v39
    v_mul_f32 v40, v156, v40
    s_waitcnt lgkmcnt(2)
    v_mfma_f32_32x32x16_bf16 v[128:143], v[208:211], v[112:115], v[128:143]
    v_mul_f32 v41, v156, v41
    v_mul_f32 v42, v156, v42
    v_mul_f32 v43, v156, v43
    v_cvt_pk_bf16_f32 v36, v40, v41
    v_cvt_pk_bf16_f32 v37, v42, v43
    v_mul_f32 v44, v156, v44
    v_mul_f32 v45, v156, v45
    v_mfma_f32_32x32x16_bf16 v[128:143], v[212:215], v[116:119], v[128:143]
    v_mul_f32 v46, v156, v46
    v_mul_f32 v47, v156, v47
    v_cvt_pk_bf16_f32 v38, v44, v45
    v_cvt_pk_bf16_f32 v39, v46, v47
    v_mul_f32 v48, v156, v48
    v_mul_f32 v49, v156, v49
    v_mul_f32 v50, v156, v50
    s_waitcnt lgkmcnt(0)
    v_mfma_f32_32x32x16_bf16 v[128:143], v[216:219], v[120:123], v[128:143]
    v_mul_f32 v51, v156, v51
    v_cvt_pk_bf16_f32 v40, v48, v49
    v_cvt_pk_bf16_f32 v41, v50, v51
    v_mul_f32 v52, v156, v52
    v_mul_f32 v53, v156, v53
    v_mul_f32 v54, v156, v54
    v_mul_f32 v55, v156, v55
    v_mfma_f32_32x32x16_bf16 v[128:143], v[220:223], v[124:127], v[128:143]
    v_cvt_pk_bf16_f32 v42, v52, v53
    v_cvt_pk_bf16_f32 v43, v54, v55
    v_mul_f32 v56, v156, v56
    v_mul_f32 v57, v156, v57
    v_mul_f32 v58, v156, v58
    v_mul_f32 v59, v156, v59
    v_cvt_pk_bf16_f32 v44, v56, v57
    s_or_b32 s35, s35, s58
    ds_write_b64 v248, v[0:1] offset:0
    v_cvt_pk_bf16_f32 v45, v58, v59
    ds_write_b64 v248, v[2:3] offset:16
    v_mul_f32 v60, v156, v60
    ds_write_b64 v248, v[4:5] offset:32
    v_mul_f32 v61, v156, v61
    ds_write_b64 v248, v[6:7] offset:48
    v_mul_f32 v62, v156, v62
    ds_write_b64 v248, v[8:9] offset:64
    v_mul_f32 v63, v156, v63
    ds_write_b64 v248, v[10:11] offset:80
    v_cvt_pk_bf16_f32 v46, v60, v61
    ds_write_b64 v248, v[12:13] offset:96
    v_cvt_pk_bf16_f32 v47, v62, v63
    ds_write_b64 v248, v[14:15] offset:112
    ds_read_b128 v[16:19], v249 offset:0
    ds_read_b128 v[20:23], v249 offset:1152
    ds_read_b128 v[24:27], v249 offset:2304
    ds_read_b128 v[28:31], v249 offset:3456
    v_sub_u32 v228, v230, v228
    v_sub_u32 v229, v231, v229
    v_sub_u32 v224, v225, v224
    ds_write_b64 v248, v[32:33] offset:0
    ds_write_b64 v248, v[34:35] offset:16
    ds_write_b64 v248, v[36:37] offset:32
    ds_write_b64 v248, v[38:39] offset:48
    ds_write_b64 v248, v[40:41] offset:64
    ds_write_b64 v248, v[42:43] offset:80
    ds_write_b64 v248, v[44:45] offset:96
    ds_write_b64 v248, v[46:47] offset:112
    ds_read_b128 v[48:51], v249 offset:0
    ds_read_b128 v[52:55], v249 offset:1152
    ds_read_b128 v[56:59], v249 offset:2304
    ds_read_b128 v[60:63], v249 offset:3456
    s_waitcnt lgkmcnt(15)
    s_add_u32 s36, s33, 0
    buffer_store_dwordx4 v[16:19], v246, s[20:23], s36 offen sc1
    s_waitcnt lgkmcnt(14)
    s_add_u32 s36, s33, 4096
    buffer_store_dwordx4 v[20:23], v246, s[20:23], s36 offen sc1
    s_waitcnt lgkmcnt(13)
    s_add_u32 s36, s33, 8192
    buffer_store_dwordx4 v[24:27], v246, s[20:23], s36 offen sc1
    s_waitcnt lgkmcnt(12)
    s_add_u32 s36, s33, 12288
    buffer_store_dwordx4 v[28:31], v246, s[20:23], s36 offen sc1
    s_waitcnt lgkmcnt(0)
    s_cbranch_vccnz L_nb5
    s_barrier
L_nb5:
    v_xor_b32 v246, 0x4000, v246
    s_add_u32 s36, s33, 0
    buffer_store_dwordx4 v[48:51], v246, s[20:23], s36 offen sc1
    ds_read_b64_tr_b16 v[176:177], v228 offset:0
    ds_read_b64_tr_b16 v[178:179], v228 offset:2080
    ds_read_b64_tr_b16 v[180:181], v228 offset:64
    ds_read_b64_tr_b16 v[182:183], v228 offset:2144
    ds_read_b128 v[152:155], v236 offset:0
    s_add_u32 s36, s33, 4096
    buffer_store_dwordx4 v[52:55], v246, s[20:23], s36 offen sc1
    ds_read_b64_tr_b16 v[184:185], v228 offset:16640
    ds_read_b64_tr_b16 v[186:187], v228 offset:18720
    ds_read_b64_tr_b16 v[188:189], v228 offset:16704
    ds_read_b64_tr_b16 v[190:191], v228 offset:18784
    ds_read_b128 v[156:159], v236 offset:1024
    s_add_u32 s36, s33, 8192
    buffer_store_dwordx4 v[56:59], v246, s[20:23], s36 offen sc1
    ds_read_b64_tr_b16 v[192:193], v229 offset:0
    ds_read_b64_tr_b16 v[194:195], v229 offset:2080
    ds_read_b64_tr_b16 v[196:197], v229 offset:64
    ds_read_b64_tr_b16 v[198:199], v229 offset:2144
    ds_read_b128 v[160:163], v235 offset:0
    s_add_u32 s36, s33, 12288
    buffer_store_dwordx4 v[60:63], v246, s[20:23], s36 offen sc1
    ds_read_b128 v[164:167], v237 offset:0
    ds_read_b64_tr_b16 v[200:201], v229 offset:16640
    v_xor_b32 v246, 0x4000, v246
    s_mov_b32 s33, s34
    s_cmp_eq_u32 s38, 1
    s_cbranch_scc1 L_vfirst
    s_branch L_vspec
L_ev2:
    s_cmp_eq_u32 s28, s41
    s_cbranch_scc1 L_qskip
    s_cmp_eq_u32 s28, 0
    s_cbranch_scc0 L_epi
    s_or_b32 s38, s39, 1
    s_branch L_q
L_epi:
    ds_read_b128 v[152:155], v239
    ds_read_b128 v[156:159], v240
    s_waitcnt lgkmcnt(0)
    s_mov_b32 s36, 0x30800000
    s_mov_b32 s37, 0x1e000000
    v_add_f32 v152, v152, v153
    v_add_f32 v154, v154, v155
    v_add_f32 v156, v156, v157
    v_add_f32 v158, v158, v159
    v_add_f32 v152, v152, v154
    v_add_f32 v156, v156, v158
    v_subrev_u32 v153, s36, v152
    v_rcp_f32 v152, v152
    v_subrev_u32 v157, s36, v156
    v_rcp_f32 v156, v156
    v_max_u32 v153, v153, v157
    v_cmp_lt_u32 s[58:59], s37, v153
    v_xor_b32 v239, 0x400, v239
    v_xor_b32 v240, 0x400, v240
    v_pk_mul_f32 v[0:1], v[0:1], v[152:153] op_sel_hi:[1,0]
    v_pk_mul_f32 v[2:3], v[2:3], v[152:153] op_sel_hi:[1,0]
    v_cvt_pk_bf16_f32 v0, v0, v1
    v_cvt_pk_bf16_f32 v1, v2, v3
    ds_write_b64 v248, v[0:1] offset:0
    v_pk_mul_f32 v[4:5], v[4:5], v[152:153] op_sel_hi:[1,0]
    v_pk_mul_f32 v[6:7], v[6:7], v[152:153] op_sel_hi:[1,0]
    v_cvt_pk_bf16_f32 v2, v4, v5
    v_cvt_pk_bf16_f32 v3, v6, v7
    ds_write_b64 v248, v[2:3] offset:16
    v_pk_mul_f32 v[8:9], v[8:9], v[152:153] op_sel_hi:[1,0]
    v_pk_mul_f32 v[10:11], v[10:11], v[152:153] op_sel_hi:[1,0]
    v_cvt_pk_bf16_f32 v4, v8, v9
    v_cvt_pk_bf16_f32 v5, v10, v11
    ds_write_b64 v248, v[4:5] offset:32
    v_pk_mul_f32 v[12:13], v[12:13], v[152:153] op_sel_hi:[1,0]
    v_pk_mul_f32 v[14:15], v[14:15], v[152:153] op_sel_hi:[1,0]
    v_cvt_pk_bf16_f32 v6, v12, v13
    v_cvt_pk_bf16_f32 v7, v14, v15
    ds_write_b64 v248, v[6:7] offset:48
    v_pk_mul_f32 v[16:17], v[16:17], v[152:153] op_sel_hi:[1,0]
    v_pk_mul_f32 v[18:19], v[18:19], v[152:153] op_sel_hi:[1,0]
    v_cvt_pk_bf16_f32 v8, v16, v17
    v_cvt_pk_bf16_f32 v9, v18, v19
    ds_write_b64 v248, v[8:9] offset:64
    v_pk_mul_f32 v[20:21], v[20:21], v[152:153] op_sel_hi:[1,0]
    v_pk_mul_f32 v[22:23], v[22:23], v[152:153] op_sel_hi:[1,0]
    v_cvt_pk_bf16_f32 v10, v20, v21
    v_cvt_pk_bf16_f32 v11, v22, v23
    ds_write_b64 v248, v[10:11] offset:80
    v_pk_mul_f32 v[24:25], v[24:25], v[152:153] op_sel_hi:[1,0]
    v_pk_mul_f32 v[26:27], v[26:27], v[152:153] op_sel_hi:[1,0]
    v_cvt_pk_bf16_f32 v12, v24, v25
    v_cvt_pk_bf16_f32 v13, v26, v27
    ds_write_b64 v248, v[12:13] offset:96
    v_pk_mul_f32 v[28:29], v[28:29], v[152:153] op_sel_hi:[1,0]
    v_pk_mul_f32 v[30:31], v[30:31], v[152:153] op_sel_hi:[1,0]
    v_cvt_pk_bf16_f32 v14, v28, v29
    v_cvt_pk_bf16_f32 v15, v30, v31
    ds_write_b64 v248, v[14:15] offset:112
    s_or_b32 s35, s35, s58
    ds_read_b128 v[16:19], v249 offset:0
    ds_read_b128 v[20:23], v249 offset:1152
    ds_read_b128 v[24:27], v249 offset:2304
    ds_read_b128 v[28:31], v249 offset:3456
    v_pk_mul_f32 v[32:33], v[32:33], v[156:157] op_sel_hi:[1,0]
    v_pk_mul_f32 v[34:35], v[34:35], v[156:157] op_sel_hi:[1,0]
    v_cvt_pk_bf16_f32 v32, v32, v33
    v_cvt_pk_bf16_f32 v33, v34, v35
    ds_write_b64 v248, v[32:33] offset:0
    v_pk_mul_f32 v[36:37], v[36:37], v[156:157] op_sel_hi:[1,0]
    v_pk_mul_f32 v[38:39], v[38:39], v[156:157] op_sel_hi:[1,0]
    v_cvt_pk_bf16_f32 v34, v36, v37
    v_cvt_pk_bf16_f32 v35, v38, v39
    ds_write_b64 v248, v[34:35] offset:16
    v_pk_mul_f32 v[40:41], v[40:41], v[156:157] op_sel_hi:[1,0]
    v_pk_mul_f32 v[42:43], v[42:43], v[156:157] op_sel_hi:[1,0]
    v_cvt_pk_bf16_f32 v36, v40, v41
    v_cvt_pk_bf16_f32 v37, v42, v43
    ds_write_b64 v248, v[36:37] offset:32
    v_pk_mul_f32 v[44:45], v[44:45], v[156:157] op_sel_hi:[1,0]
    v_pk_mul_f32 v[46:47], v[46:47], v[156:157] op_sel_hi:[1,0]
    v_cvt_pk_bf16_f32 v38, v44, v45
    v_cvt_pk_bf16_f32 v39, v46, v47
    ds_write_b64 v248, v[38:39] offset:48
    v_pk_mul_f32 v[48:49], v[48:49], v[156:157] op_sel_hi:[1,0]
    v_pk_mul_f32 v[50:51], v[50:51], v[156:157] op_sel_hi:[1,0]
    v_cvt_pk_bf16_f32 v40, v48, v49
    v_cvt_pk_bf16_f32 v41, v50, v51
    ds_write_b64 v248, v[40:41] offset:64
    s_waitcnt lgkmcnt(8)
    s_add_u32 s36, s33, 0
    buffer_store_dwordx4 v[16:19], v246, s[20:23], s36 offen sc1
    v_pk_mul_f32 v[52:53], v[52:53], v[156:157] op_sel_hi:[1,0]
    v_pk_mul_f32 v[54:55], v[54:55], v[156:157] op_sel_hi:[1,0]
    v_cvt_pk_bf16_f32 v42, v52, v53
    v_cvt_pk_bf16_f32 v43, v54, v55
    ds_write_b64 v248, v[42:43] offset:80
    s_waitcnt lgkmcnt(8)
    s_add_u32 s36, s33, 4096
    buffer_store_dwordx4 v[20:23], v246, s[20:23], s36 offen sc1
    v_pk_mul_f32 v[56:57], v[56:57], v[156:157] op_sel_hi:[1,0]
    v_pk_mul_f32 v[58:59], v[58:59], v[156:157] op_sel_hi:[1,0]
    v_cvt_pk_bf16_f32 v44, v56, v57
    v_cvt_pk_bf16_f32 v45, v58, v59
    ds_write_b64 v248, v[44:45] offset:96
    s_waitcnt lgkmcnt(8)
    s_add_u32 s36, s33, 8192
    buffer_store_dwordx4 v[24:27], v246, s[20:23], s36 offen sc1
    v_pk_mul_f32 v[60:61], v[60:61], v[156:157] op_sel_hi:[1,0]
    v_pk_mul_f32 v[62:63], v[62:63], v[156:157] op_sel_hi:[1,0]
    v_cvt_pk_bf16_f32 v46, v60, v61
    v_cvt_pk_bf16_f32 v47, v62, v63
    ds_write_b64 v248, v[46:47] offset:112
    s_waitcnt lgkmcnt(8)
    s_add_u32 s36, s33, 12288
    buffer_store_dwordx4 v[28:31], v246, s[20:23], s36 offen sc1
    ds_read_b128 v[48:51], v249 offset:0
    ds_read_b128 v[52:55], v249 offset:1152
    ds_read_b128 v[56:59], v249 offset:2304
    ds_read_b128 v[60:63], v249 offset:3456
    v_xor_b32 v246, 0x4000, v246
    s_waitcnt lgkmcnt(3)
    s_add_u32 s36, s33, 0
    buffer_store_dwordx4 v[48:51], v246, s[20:23], s36 offen sc1
    s_waitcnt lgkmcnt(2)
    s_add_u32 s36, s33, 4096
    buffer_store_dwordx4 v[52:55], v246, s[20:23], s36 offen sc1
    s_waitcnt lgkmcnt(1)
    s_add_u32 s36, s33, 8192
    buffer_store_dwordx4 v[56:59], v246, s[20:23], s36 offen sc1
    s_waitcnt lgkmcnt(0)
    s_add_u32 s36, s33, 12288
    buffer_store_dwordx4 v[60:63], v246, s[20:23], s36 offen sc1
    v_xor_b32 v246, 0x4000, v246
    s_mov_b32 s33, s34
    s_cmp_eq_u32 s28, s30
    s_cbranch_scc0 L_qskip
L_done:
    s_cmp_lg_u32 s35, 0
    s_cselect_b32 s36, 1, 0
    s_cmp_eq_u32 s27, 1
    s_cselect_b32 s36, 2, s36
    s_cmp_eq_u32 s27, 2
    s_cselect_b32 s27, 0, s36
    v_mov_b32 v250, s27
    ds_write_b32 v251, v250 offset:144
    ds_write_b32 v247, v245
    s_waitcnt lgkmcnt(0)
    s_barrier
    s_cmp_eq_u32 s27, 0
    s_cbranch_scc1 L_end
    s_waitcnt vmcnt(0)
    s_cmp_eq_u32 s27, 1
    s_cbranch_scc1 L_cpass
    ds_read_b128 v[152:155], v239 offset:2048
    ds_read_b128 v[156:159], v239 offset:3072
    s_waitcnt lgkmcnt(0)
    v_max3_f32 v152, v152, v153, v154
    v_max3_f32 v156, v156, v157, v158
    v_max_f32 v152, v152, v155
    v_max_f32 v156, v156, v159
    v_mul_f32 v243, s31, v152
    v_mul_f32 v244, s32, v156
    v_sub_f32 v243, 0, v243
    v_sub_f32 v244, 0, v244
    s_branch L_cpass
L_end:
    s_endpgm
.section .rodata,"a"
.p2align 6
.amdhsa_kernel standalone__block_sparse_attn__prompt_kernel
  .amdhsa_next_free_vgpr 256
  .amdhsa_next_free_sgpr 96
  .amdhsa_accum_offset 256
  .amdhsa_group_segment_fixed_size 0
  .amdhsa_kernarg_size 56
  .amdhsa_user_sgpr_count 2
  .amdhsa_user_sgpr_kernarg_segment_ptr 1
  .amdhsa_system_sgpr_workgroup_id_x 1
.end_amdhsa_kernel
```
